```python
import torch

def _softmax(x, axis=-1):
    return torch.softmax(x, dim=axis)
def _gelu(x):
    return torch.nn.functional.gelu(x, approximate="tanh")
def _silu(x):
    return torch.nn.functional.silu(x)
def _sigmoid(x):
    return torch.sigmoid(x)
def _layernorm(x, axis=-1, eps=1e-5):
    m = x.mean(dim=axis, keepdim=True)
    v = x.var(dim=axis, keepdim=True, unbiased=False)
    return (x - m) / torch.sqrt(v + eps)
def _scatter_add(tgt, idx, src, axis=0):
    return tgt.clone().index_add_(axis, idx, src)
def _segment_sum(src, seg, n):
    out = torch.zeros((n,) + src.shape[1:], dtype=src.dtype)
    return out.index_add_(0, seg, src)
def _pad(x, pw):
    flat = tuple(v for pair in reversed(pw) for v in pair)
    return torch.nn.functional.pad(x, flat)

kernel_name = 'standalone__channel_attn_se__vision'

def setup_inputs():

    _w = (lambda a: (lambda t: t.to(torch.bfloat16) if t.is_floating_point() else t)(torch.as_tensor(a)))
    H = W = 512
    C = 192
    r = max(C // 16, 4)
    return {
        "x": _w((lambda *s: torch.randn(*s, dtype=torch.bfloat16) * 3.2)(1, H, W, C)),
        "w_down": _w((lambda *s: torch.randn(*s, dtype=torch.bfloat16) * 3.2)(C, r)),
        "w_up": _w((lambda *s: torch.randn(*s, dtype=torch.bfloat16) * 3.2)(r, C)),
    }

def reference(x, w_down, w_up):
    s = x.mean(axis=(1, 2))
    h = _silu(torch.einsum('bc,cr->br', s, w_down))
    g = _sigmoid(torch.einsum('br,rc->bc', h, w_up))
    return x * g[:, None, None, :]
```

```asm
; @launch grid=(256,1,1) block=(768,1,1) lds=20480
.amdgcn_target "amdgcn-amd-amdhsa--gfx950"
.text
.globl standalone__channel_attn_se__vision_kernel
.p2align 8
.type standalone__channel_attn_se__vision_kernel,@function
standalone__channel_attn_se__vision_kernel:
    s_cmp_ge_u32 s2, 256
    s_cbranch_scc1 L_exit
    s_load_dwordx2 s[16:17], s[0:1], 0
    s_load_dwordx2 s[20:21], s[0:1], 24
    s_load_dwordx2 s[24:25], s[0:1], 40
    s_load_dwordx4 s[12:15], s[0:1], 8
    v_lshrrev_b32 v1, 6, v0
    v_and_b32 v2, 63, v0
    v_readfirstlane_b32 s3, v1
    v_lshrrev_b32 v3, 4, v2
    v_and_b32 v4, 15, v2
    v_mul_u32_u24 v5, 768, v3
    s_mul_i32 s40, s3, 11
    s_lshr_b32 s40, s40, 5
    s_mul_i32 s41, s40, 3
    s_sub_u32 s41, s3, s41
    s_lshl_b32 s43, s41, 8
    v_lshl_add_u32 v5, v4, 4, v5
    v_add_u32 v5, s43, v5
    s_mov_b32 s18, 100663296
    s_mov_b32 s19, 0x00020000
    s_lshr_b32 s42, s2, 3
    s_and_b32 s43, s2, 3
    s_lshl2_add_u32 s42, s42, s43
    s_mul_i32 s76, s42, 49152
    s_mul_i32 s78, s40, 6144
    s_add_u32 s78, s78, s76
    s_add_u32 s80, s78, 24576
    s_bitcmp1_b32 s2, 2
    s_cselect_b32 s82, s80, s78
    s_add_u32 s83, s82, 3072
    s_add_u32 s44, s82, 0
    s_add_u32 s45, s83, 0
    s_add_u32 s46, s82, 6291456
    s_add_u32 s47, s83, 6291456
    s_waitcnt lgkmcnt(0)
    buffer_load_dwordx4 v[40:43], v5, s[16:19], s44 offen nt
    buffer_load_dwordx4 v[44:47], v5, s[16:19], s45 offen nt
    buffer_load_dwordx4 v[48:51], v5, s[16:19], s46 offen nt
    s_add_u32 s48, s82, 12582912
    s_add_u32 s49, s83, 12582912
    s_add_u32 s50, s82, 18874368
    s_add_u32 s51, s83, 18874368
    s_add_u32 s52, s82, 25165824
    s_add_u32 s53, s83, 25165824
    s_add_u32 s54, s82, 31457280
    s_add_u32 s55, s83, 31457280
    s_add_u32 s56, s82, 62914560
    s_add_u32 s57, s83, 62914560
    s_add_u32 s58, s82, 69206016
    s_add_u32 s59, s83, 69206016
    s_add_u32 s60, s82, 37748736
    s_add_u32 s61, s83, 37748736
    s_add_u32 s62, s82, 75497472
    s_add_u32 s63, s83, 75497472
    s_add_u32 s64, s82, 44040192
    s_add_u32 s65, s83, 44040192
    s_add_u32 s66, s82, 81788928
    s_add_u32 s67, s83, 81788928
    s_add_u32 s68, s82, 50331648
    s_add_u32 s69, s83, 50331648
    s_add_u32 s70, s82, 88080384
    s_add_u32 s71, s83, 88080384
    s_add_u32 s72, s82, 56623104
    s_add_u32 s73, s83, 56623104
    s_add_u32 s74, s82, 94371840
    s_add_u32 s75, s83, 94371840
    s_mov_b32 s22, 100663296
    s_mov_b32 s23, 0x00020000
    s_mov_b32 s26, 2097152
    s_mov_b32 s27, 0x00020000
    s_mov_b32 s30, 0xffff0000
    s_mov_b32 s31, 4000000
    s_mov_b32 s87, 393216
    s_mov_b32 s86, 0
    s_cmp_gt_u32 s3, 3
    s_cbranch_scc1 L_norole
    s_cmp_eq_u32 s3, 0
    s_cbranch_scc1 L_wave0
    s_cmp_eq_u32 s3, 3
    s_cbranch_scc1 L_wave3
    s_branch L_norole
L_wave3:
    s_load_dword s4, s[12:13], 0
    s_load_dword s5, s[14:15], 0
    s_branch L_norole
L_wave0:
    s_load_dword s28, s[24:25], 401408
    s_getreg_b32 s89, hwreg(HW_REG_XCC_ID)
    s_and_b32 s89, s89, 7
    s_mov_b32 s38, 0
    s_mov_b32 s86, 2
    s_bitcmp1_b32 s89, 0
    s_cbranch_scc1 L_pubvote
    s_mov_b32 s86, 1
    s_bfe_u32 s42, s2, 0x10006
    s_add_u32 s42, s42, 1
    s_mul_i32 s42, s42, 41943040
    s_bfe_u32 s43, s2, 0x30003
    s_lshl_b32 s43, s43, 21
    s_add_u32 s42, s42, s43
    s_lshr_b32 s43, s2, 7
    s_lshl_b32 s43, s43, 19
    s_add_u32 s42, s42, s43
    s_and_b32 s43, s2, 7
    s_lshl_b32 s43, s43, 16
    s_add_u32 s42, s42, s43
    s_and_b32 s43, s20, 0xffe00000
    s_add_u32 s6, s43, s42
    s_addc_u32 s7, s21, 0
    s_load_dword s4, s[6:7], 4096
    buffer_load_dwordx4 v[52:55], v5, s[16:19], s47 offen nt
    buffer_load_dwordx4 v[56:59], v5, s[16:19], s48 offen nt
    buffer_load_dwordx4 v[60:63], v5, s[16:19], s49 offen nt
    buffer_load_dwordx4 v[64:67], v5, s[16:19], s50 offen nt
    s_waitcnt lgkmcnt(0)
    s_memtime s[32:33]
    s_waitcnt lgkmcnt(0)
    s_load_dword s4, s[6:7], 0
    s_waitcnt lgkmcnt(0)
    s_memtime s[34:35]
    s_waitcnt lgkmcnt(0)
    s_sub_u32 s8, s34, s32
    s_load_dword s4, s[6:7], 8192
    s_waitcnt lgkmcnt(0)
    s_memtime s[32:33]
    s_waitcnt lgkmcnt(0)
    s_sub_u32 s9, s32, s34
    s_cmp_gt_u32 s9, s8
    s_cselect_b32 s39, 16, -16
    s_add_i32 s38, s38, s39
    s_lshr_b32 s42, s2, 1
    s_xor_b32 s42, s42, s89
    s_sub_i32 s39, 0, s38
    s_bitcmp1_b32 s42, 2
    s_cselect_b32 s38, s39, s38
L_pubvote:
    s_waitcnt lgkmcnt(0)
    s_or_b32 s38, s38, s89
    s_add_u32 s39, s28, 1
    s_xor_b32 s39, s39, 0x2c1b3c6d
    s_xor_b32 s39, s39, s38
    s_lshl_b32 s42, s2, 3
    v_mov_b32 v32, s38
    v_mov_b32 v33, s39
    v_mov_b32 v34, s42
    s_mov_b64 exec, 1
    buffer_store_dwordx2 v[32:33], v34, s[24:27], s87 offen sc1
    s_mov_b64 exec, -1
L_norole:
    v_lshlrev_b32 v1, 4, v2
    s_waitcnt vmcnt(2)
    s_cmp_eq_u32 s86, 1
    s_cbranch_scc1 L_sk3
    buffer_load_dwordx4 v[52:55], v5, s[16:19], s47 offen nt
L_sk3:
    v_lshlrev_b32 v8, 16, v40
    v_and_b32 v9, s30, v40
    v_lshlrev_b32 v10, 16, v41
    v_and_b32 v11, s30, v41
    v_lshlrev_b32 v12, 16, v42
    v_and_b32 v13, s30, v42
    v_lshlrev_b32 v14, 16, v43
    v_and_b32 v15, s30, v43
    s_waitcnt vmcnt(2)
    s_cmp_eq_u32 s86, 1
    s_cbranch_scc1 L_sk4
    buffer_load_dwordx4 v[56:59], v5, s[16:19], s48 offen nt
L_sk4:
    v_lshlrev_b32 v16, 16, v44
    v_and_b32 v17, s30, v44
    v_lshlrev_b32 v18, 16, v45
    v_and_b32 v19, s30, v45
    v_lshlrev_b32 v20, 16, v46
    v_and_b32 v21, s30, v46
    v_lshlrev_b32 v22, 16, v47
    v_and_b32 v23, s30, v47
    v_pk_add_f32 v[8:9], v[8:9], v[16:17]
    v_pk_add_f32 v[10:11], v[10:11], v[18:19]
    v_pk_add_f32 v[12:13], v[12:13], v[20:21]
    v_pk_add_f32 v[14:15], v[14:15], v[22:23]
    s_waitcnt vmcnt(2)
    s_cmp_eq_u32 s86, 1
    s_cbranch_scc1 L_sk5
    buffer_load_dwordx4 v[60:63], v5, s[16:19], s49 offen nt
L_sk5:
    v_lshlrev_b32 v16, 16, v48
    v_and_b32 v17, s30, v48
    v_lshlrev_b32 v18, 16, v49
    v_and_b32 v19, s30, v49
    v_lshlrev_b32 v20, 16, v50
    v_and_b32 v21, s30, v50
    v_lshlrev_b32 v22, 16, v51
    v_and_b32 v23, s30, v51
    v_pk_add_f32 v[8:9], v[8:9], v[16:17]
    v_pk_add_f32 v[10:11], v[10:11], v[18:19]
    v_pk_add_f32 v[12:13], v[12:13], v[20:21]
    v_pk_add_f32 v[14:15], v[14:15], v[22:23]
    s_waitcnt vmcnt(2)
    s_cmp_eq_u32 s86, 1
    s_cbranch_scc1 L_sk6
    buffer_load_dwordx4 v[64:67], v5, s[16:19], s50 offen nt
L_sk6:
    v_lshlrev_b32 v16, 16, v52
    v_and_b32 v17, s30, v52
    v_lshlrev_b32 v18, 16, v53
    v_and_b32 v19, s30, v53
    v_lshlrev_b32 v20, 16, v54
    v_and_b32 v21, s30, v54
    v_lshlrev_b32 v22, 16, v55
    v_and_b32 v23, s30, v55
    v_pk_add_f32 v[8:9], v[8:9], v[16:17]
    v_pk_add_f32 v[10:11], v[10:11], v[18:19]
    v_pk_add_f32 v[12:13], v[12:13], v[20:21]
    v_pk_add_f32 v[14:15], v[14:15], v[22:23]
    s_waitcnt vmcnt(2)
    buffer_load_dwordx4 v[68:71], v5, s[16:19], s51 offen nt
    v_lshlrev_b32 v16, 16, v56
    v_and_b32 v17, s30, v56
    v_lshlrev_b32 v18, 16, v57
    v_and_b32 v19, s30, v57
    v_lshlrev_b32 v20, 16, v58
    v_and_b32 v21, s30, v58
    v_lshlrev_b32 v22, 16, v59
    v_and_b32 v23, s30, v59
    v_pk_add_f32 v[8:9], v[8:9], v[16:17]
    v_pk_add_f32 v[10:11], v[10:11], v[18:19]
    v_pk_add_f32 v[12:13], v[12:13], v[20:21]
    v_pk_add_f32 v[14:15], v[14:15], v[22:23]
    s_cmp_lt_u32 s3, 5
    s_cselect_b32 s36, s14, s12
    s_cselect_b32 s37, s15, s13
    s_cselect_b32 s42, 0, 5120
    s_mov_b32 s38, 4608
    s_mov_b32 s39, 0x00020000
    s_lshl_b32 s43, s3, 10
    s_add_u32 m0, s43, 8192
    s_sub_u32 s43, s43, s42
    buffer_load_dwordx4 v1, s[36:39], s43 offen lds
    s_waitcnt vmcnt(2)
    buffer_load_dwordx4 v[72:75], v5, s[16:19], s52 offen nt
    v_lshlrev_b32 v16, 16, v60
    v_and_b32 v17, s30, v60
    v_lshlrev_b32 v18, 16, v61
    v_and_b32 v19, s30, v61
    v_lshlrev_b32 v20, 16, v62
    v_and_b32 v21, s30, v62
    v_lshlrev_b32 v22, 16, v63
    v_and_b32 v23, s30, v63
    v_pk_add_f32 v[8:9], v[8:9], v[16:17]
    v_pk_add_f32 v[10:11], v[10:11], v[18:19]
    v_pk_add_f32 v[12:13], v[12:13], v[20:21]
    v_pk_add_f32 v[14:15], v[14:15], v[22:23]
    s_waitcnt vmcnt(2)
    buffer_load_dwordx4 v[76:79], v5, s[16:19], s53 offen nt
    v_lshlrev_b32 v16, 16, v64
    v_and_b32 v17, s30, v64
    v_lshlrev_b32 v18, 16, v65
    v_and_b32 v19, s30, v65
    v_lshlrev_b32 v20, 16, v66
    v_and_b32 v21, s30, v66
    v_lshlrev_b32 v22, 16, v67
    v_and_b32 v23, s30, v67
    v_pk_add_f32 v[8:9], v[8:9], v[16:17]
    v_pk_add_f32 v[10:11], v[10:11], v[18:19]
    v_pk_add_f32 v[12:13], v[12:13], v[20:21]
    v_pk_add_f32 v[14:15], v[14:15], v[22:23]
    s_cmp_eq_u32 s3, 5
    s_cbranch_scc1 L_stub
L_stubret:
    s_waitcnt vmcnt(2)
    buffer_load_dwordx4 v[80:83], v5, s[16:19], s54 offen nt
    v_lshlrev_b32 v16, 16, v68
    v_and_b32 v17, s30, v68
    v_lshlrev_b32 v18, 16, v69
    v_and_b32 v19, s30, v69
    v_lshlrev_b32 v20, 16, v70
    v_and_b32 v21, s30, v70
    v_lshlrev_b32 v22, 16, v71
    v_and_b32 v23, s30, v71
    v_pk_add_f32 v[8:9], v[8:9], v[16:17]
    v_pk_add_f32 v[10:11], v[10:11], v[18:19]
    v_pk_add_f32 v[12:13], v[12:13], v[20:21]
    v_pk_add_f32 v[14:15], v[14:15], v[22:23]
    s_load_dword s28, s[24:25], 401408
    s_cmp_gt_u32 s3, 2
    s_cbranch_scc1 L_noto
    s_lshr_b32 s42, s2, 3
    s_and_b32 s43, s42, 15
    s_add_u32 s43, s43, 32
    s_cmp_eq_u32 s3, 1
    s_cselect_b32 s42, s42, s43
    s_lshl_b32 s42, s42, 21
    s_load_dword s10, s[20:21], s42
L_noto:
    s_waitcnt vmcnt(2)
    buffer_load_dwordx4 v[84:87], v5, s[16:19], s55 offen nt
    v_lshlrev_b32 v16, 16, v72
    v_and_b32 v17, s30, v72
    v_lshlrev_b32 v18, 16, v73
    v_and_b32 v19, s30, v73
    v_lshlrev_b32 v20, 16, v74
    v_and_b32 v21, s30, v74
    v_lshlrev_b32 v22, 16, v75
    v_and_b32 v23, s30, v75
    v_pk_add_f32 v[8:9], v[8:9], v[16:17]
    v_pk_add_f32 v[10:11], v[10:11], v[18:19]
    v_pk_add_f32 v[12:13], v[12:13], v[20:21]
    v_pk_add_f32 v[14:15], v[14:15], v[22:23]
    s_and_b32 s42, s20, 0x1fffff
    s_add_u32 s43, s42, 1536
    s_lshr_b32 s43, s43, 10
    s_lshl_b32 s78, s40, 1
    s_sub_u32 s78, s78, s43
    s_mul_i32 s78, s78, 11
    s_add_u32 s79, s78, 11
    s_and_b32 s78, s78, 15
    s_and_b32 s79, s79, 15
    s_xor_b32 s80, s78, 8
    s_xor_b32 s81, s79, 8
    s_mul_i32 s78, s78, 3072
    s_add_u32 s78, s78, s76
    s_mul_i32 s79, s79, 3072
    s_add_u32 s79, s79, s76
    s_mul_i32 s80, s80, 3072
    s_add_u32 s80, s80, s76
    s_mul_i32 s81, s81, 3072
    s_add_u32 s81, s81, s76
    s_add_u32 s77, s76, 24576
    s_add_u32 s77, s77, s42
    s_lshr_b32 s77, s77, 19
    s_xor_b32 s77, s77, s2
    s_waitcnt vmcnt(2)
    buffer_load_dwordx4 v[88:91], v5, s[16:19], s56 offen nt
    v_lshlrev_b32 v16, 16, v76
    v_and_b32 v17, s30, v76
    v_lshlrev_b32 v18, 16, v77
    v_and_b32 v19, s30, v77
    v_lshlrev_b32 v20, 16, v78
    v_and_b32 v21, s30, v78
    v_lshlrev_b32 v22, 16, v79
    v_and_b32 v23, s30, v79
    v_pk_add_f32 v[8:9], v[8:9], v[16:17]
    v_pk_add_f32 v[10:11], v[10:11], v[18:19]
    v_pk_add_f32 v[12:13], v[12:13], v[20:21]
    v_pk_add_f32 v[14:15], v[14:15], v[22:23]
    s_cmp_lg_u32 s3, 4
    s_cbranch_scc1 L_nozr
    v_and_b32 v36, 48, v1
    v_lshrrev_b32 v37, 2, v2
    v_mul_u32_u24 v37, 20480, v37
    v_add_u32 v36, v36, v37
    v_mov_b32 v32, 0
    v_mov_b32 v33, 0
    v_mov_b32 v34, 0
    v_mov_b32 v35, 0
    s_lshl_b32 s42, s2, 6
    s_mov_b32 exec_hi, 0
    buffer_store_dwordx4 v[32:35], v36, s[24:27], s42 offen sc1
    s_mov_b32 exec_hi, -1
L_nozr:
    s_waitcnt vmcnt(2)
    buffer_load_dwordx4 v[92:95], v5, s[16:19], s57 offen nt
    v_lshlrev_b32 v16, 16, v80
    v_and_b32 v17, s30, v80
    v_lshlrev_b32 v18, 16, v81
    v_and_b32 v19, s30, v81
    v_lshlrev_b32 v20, 16, v82
    v_and_b32 v21, s30, v82
    v_lshlrev_b32 v22, 16, v83
    v_and_b32 v23, s30, v83
    v_pk_add_f32 v[8:9], v[8:9], v[16:17]
    v_pk_add_f32 v[10:11], v[10:11], v[18:19]
    v_pk_add_f32 v[12:13], v[12:13], v[20:21]
    v_pk_add_f32 v[14:15], v[14:15], v[22:23]
    s_waitcnt vmcnt(2)
    buffer_load_dwordx4 v[96:99], v5, s[16:19], s58 offen nt
    s_cmp_lg_u32 s3, 1
    s_cbranch_scc1 L_nog
    buffer_load_dwordx4 v[32:35], v1, s[24:27], s87 offen sc1
    buffer_load_dwordx4 v[36:39], v1, s[24:27], s87 offen offset:1024 sc1
L_nog:
    v_lshlrev_b32 v16, 16, v84
    v_and_b32 v17, s30, v84
    v_lshlrev_b32 v18, 16, v85
    v_and_b32 v19, s30, v85
    v_lshlrev_b32 v20, 16, v86
    v_and_b32 v21, s30, v86
    v_lshlrev_b32 v22, 16, v87
    v_and_b32 v23, s30, v87
    v_pk_add_f32 v[8:9], v[8:9], v[16:17]
    v_pk_add_f32 v[10:11], v[10:11], v[18:19]
    v_pk_add_f32 v[12:13], v[12:13], v[20:21]
    v_pk_add_f32 v[14:15], v[14:15], v[22:23]
    s_waitcnt vmcnt(2)
    buffer_load_dwordx4 v[100:103], v5, s[16:19], s59 offen nt
    v_lshlrev_b32 v16, 16, v88
    v_and_b32 v17, s30, v88
    v_lshlrev_b32 v18, 16, v89
    v_and_b32 v19, s30, v89
    v_lshlrev_b32 v20, 16, v90
    v_and_b32 v21, s30, v90
    v_lshlrev_b32 v22, 16, v91
    v_and_b32 v23, s30, v91
    v_pk_add_f32 v[8:9], v[8:9], v[16:17]
    v_pk_add_f32 v[10:11], v[10:11], v[18:19]
    v_pk_add_f32 v[12:13], v[12:13], v[20:21]
    v_pk_add_f32 v[14:15], v[14:15], v[22:23]
    s_waitcnt vmcnt(2)
    s_waitcnt lgkmcnt(0)
    s_add_u32 s28, s28, 1
    s_xor_b32 s29, s28, 0x5bd1e995
    s_cmp_lg_u32 s3, 1
    s_cbranch_scc1 L_decbar
    s_xor_b32 s88, s28, 0x2c1b3c6d
    s_waitcnt vmcnt(1)
L_vchk:
    v_bitop3_b32 v28, v32, v33, s88 bitop3:0x96
    v_bitop3_b32 v29, v34, v35, s88 bitop3:0x96
    v_bitop3_b32 v30, v36, v37, s88 bitop3:0x96
    v_bitop3_b32 v27, v38, v39, s88 bitop3:0x96
    v_or3_b32 v28, v28, v29, v30
    v_or_b32 v28, v28, v27
    v_cmp_ne_u32 vcc, 0, v28
    s_cbranch_vccz L_vok
    s_sub_u32 s31, s31, 1
    s_cbranch_scc1 L_vok
    buffer_load_dwordx4 v[32:35], v1, s[24:27], s87 offen sc1
    buffer_load_dwordx4 v[36:39], v1, s[24:27], s87 offen offset:1024 sc1
    s_waitcnt vmcnt(0)
    s_branch L_vchk
L_vok:
    s_and_b32 s42, s2, 0x7b
    s_lshr_b32 s42, s42, 1
    v_readlane_b32 s4, v32, s42
    v_readlane_b32 s5, v34, s42
    v_readlane_b32 s6, v36, s42
    v_readlane_b32 s7, v38, s42
    v_ashrrev_i32 v28, 4, v32
    v_ashrrev_i32 v29, 4, v34
    v_ashrrev_i32 v30, 4, v36
    v_ashrrev_i32 v27, 4, v38
    v_add3_u32 v28, v28, v29, v30
    v_add_u32 v28, v28, v27
    s_bitcmp1_b32 s2, 0
    s_cselect_b32 s4, s5, s4
    s_cselect_b32 s6, s7, s6
    s_bitcmp1_b32 s2, 7
    s_cselect_b32 s4, s6, s4
    s_nop 1
    v_add_u32_dpp v28, v28, v28 row_shr:1 row_mask:0xf bank_mask:0xf bound_ctrl:0
    s_nop 1
    v_add_u32_dpp v28, v28, v28 row_shr:2 row_mask:0xf bank_mask:0xf bound_ctrl:0
    s_nop 1
    v_add_u32_dpp v28, v28, v28 row_shr:4 row_mask:0xf bank_mask:0xf bound_ctrl:0
    s_nop 1
    v_add_u32_dpp v28, v28, v28 row_shr:8 row_mask:0xf bank_mask:0xf bound_ctrl:0
    s_nop 1
    v_add_u32_dpp v28, v28, v28 row_bcast:15 row_mask:0xa bank_mask:0xf
    v_lshrrev_b32 v30, 3, v2
    v_and_b32 v30, 4, v30
    v_mov_b32 v29, s4
    s_mov_b32 exec_lo, 0x80000000
    s_mov_b32 exec_hi, 0x80000000
    ds_write_b32 v30, v28 offset:7424
    ds_write_b32 v30, v29 offset:7432
    s_mov_b64 exec, -1
    s_waitcnt lgkmcnt(0)
L_decbar:
    s_barrier
    v_mov_b32 v28, 0
    ds_read_b96 v[28:30], v28 offset:7424
    s_waitcnt lgkmcnt(0)
    v_readfirstlane_b32 s4, v28
    v_readfirstlane_b32 s5, v29
    v_readfirstlane_b32 s6, v30
    s_xor_b32 s42, s16, s20
    s_lshr_b32 s42, s42, 12
    s_or_b32 s42, s42, s6
    s_bitcmp1_b32 s42, 0
    s_cbranch_scc0 L_nodec
    s_xor_b32 s77, s77, s6
    s_abs_i32 s42, s4
    s_cmp_lt_u32 s42, 14
    s_cbranch_scc1 L_keep0
    s_lshr_b32 s42, s4, 29
    s_xor_b32 s42, s42, s77
    s_bitcmp1_b32 s42, 2
    s_cselect_b32 s82, s80, s78
    s_cselect_b32 s83, s81, s79
    s_cselect_b32 s84, s78, s80
    s_cselect_b32 s85, s79, s81
    s_add_u32 s60, s82, 37748736
    s_add_u32 s61, s83, 37748736
    s_add_u32 s64, s84, 44040192
    s_add_u32 s65, s85, 44040192
    s_add_u32 s68, s82, 50331648
    s_add_u32 s69, s83, 50331648
    s_add_u32 s72, s84, 56623104
    s_add_u32 s73, s85, 56623104
L_keep0:
    s_abs_i32 s42, s5
    s_cmp_lt_u32 s42, 14
    s_cbranch_scc1 L_keep1
    s_lshr_b32 s42, s5, 29
    s_xor_b32 s42, s42, s77
    s_bitcmp1_b32 s42, 2
    s_cselect_b32 s82, s80, s78
    s_cselect_b32 s83, s81, s79
    s_cselect_b32 s84, s78, s80
    s_cselect_b32 s85, s79, s81
    s_add_u32 s62, s82, 75497472
    s_add_u32 s63, s83, 75497472
    s_add_u32 s66, s84, 81788928
    s_add_u32 s67, s85, 81788928
    s_add_u32 s70, s82, 88080384
    s_add_u32 s71, s83, 88080384
    s_add_u32 s74, s84, 94371840
    s_add_u32 s75, s85, 94371840
L_keep1:
L_nodec:
    buffer_load_dwordx4 v[104:107], v5, s[16:19], s60 offen nt
    v_lshlrev_b32 v16, 16, v92
    v_and_b32 v17, s30, v92
    v_lshlrev_b32 v18, 16, v93
    v_and_b32 v19, s30, v93
    v_lshlrev_b32 v20, 16, v94
    v_and_b32 v21, s30, v94
    v_lshlrev_b32 v22, 16, v95
    v_and_b32 v23, s30, v95
    v_pk_add_f32 v[8:9], v[8:9], v[16:17]
    v_pk_add_f32 v[10:11], v[10:11], v[18:19]
    v_pk_add_f32 v[12:13], v[12:13], v[20:21]
    v_pk_add_f32 v[14:15], v[14:15], v[22:23]
    s_waitcnt vmcnt(2)
    buffer_load_dwordx4 v[108:111], v5, s[16:19], s61 offen nt
    v_lshlrev_b32 v16, 16, v96
    v_and_b32 v17, s30, v96
    v_lshlrev_b32 v18, 16, v97
    v_and_b32 v19, s30, v97
    v_lshlrev_b32 v20, 16, v98
    v_and_b32 v21, s30, v98
    v_lshlrev_b32 v22, 16, v99
    v_and_b32 v23, s30, v99
    v_pk_add_f32 v[8:9], v[8:9], v[16:17]
    v_pk_add_f32 v[10:11], v[10:11], v[18:19]
    v_pk_add_f32 v[12:13], v[12:13], v[20:21]
    v_pk_add_f32 v[14:15], v[14:15], v[22:23]
    s_waitcnt vmcnt(2)
    buffer_load_dwordx4 v[112:115], v5, s[16:19], s62 offen nt
    v_lshlrev_b32 v16, 16, v100
    v_and_b32 v17, s30, v100
    v_lshlrev_b32 v18, 16, v101
    v_and_b32 v19, s30, v101
    v_lshlrev_b32 v20, 16, v102
    v_and_b32 v21, s30, v102
    v_lshlrev_b32 v22, 16, v103
    v_and_b32 v23, s30, v103
    v_pk_add_f32 v[8:9], v[8:9], v[16:17]
    v_pk_add_f32 v[10:11], v[10:11], v[18:19]
    v_pk_add_f32 v[12:13], v[12:13], v[20:21]
    v_pk_add_f32 v[14:15], v[14:15], v[22:23]
    s_waitcnt vmcnt(2)
    buffer_load_dwordx4 v[116:119], v5, s[16:19], s63 offen nt
    v_lshlrev_b32 v16, 16, v104
    v_and_b32 v17, s30, v104
    v_lshlrev_b32 v18, 16, v105
    v_and_b32 v19, s30, v105
    v_lshlrev_b32 v20, 16, v106
    v_and_b32 v21, s30, v106
    v_lshlrev_b32 v22, 16, v107
    v_and_b32 v23, s30, v107
    v_pk_add_f32 v[8:9], v[8:9], v[16:17]
    v_pk_add_f32 v[10:11], v[10:11], v[18:19]
    v_pk_add_f32 v[12:13], v[12:13], v[20:21]
    v_pk_add_f32 v[14:15], v[14:15], v[22:23]
    s_waitcnt vmcnt(2)
    buffer_load_dwordx4 v[120:123], v5, s[16:19], s64 offen nt
    v_lshlrev_b32 v16, 16, v108
    v_and_b32 v17, s30, v108
    v_lshlrev_b32 v18, 16, v109
    v_and_b32 v19, s30, v109
    v_lshlrev_b32 v20, 16, v110
    v_and_b32 v21, s30, v110
    v_lshlrev_b32 v22, 16, v111
    v_and_b32 v23, s30, v111
    v_pk_add_f32 v[8:9], v[8:9], v[16:17]
    v_pk_add_f32 v[10:11], v[10:11], v[18:19]
    v_pk_add_f32 v[12:13], v[12:13], v[20:21]
    v_pk_add_f32 v[14:15], v[14:15], v[22:23]
    s_waitcnt vmcnt(2)
    buffer_load_dwordx4 v[124:127], v5, s[16:19], s65 offen nt
    v_lshlrev_b32 v16, 16, v112
    v_and_b32 v17, s30, v112
    v_lshlrev_b32 v18, 16, v113
    v_and_b32 v19, s30, v113
    v_lshlrev_b32 v20, 16, v114
    v_and_b32 v21, s30, v114
    v_lshlrev_b32 v22, 16, v115
    v_and_b32 v23, s30, v115
    v_pk_add_f32 v[8:9], v[8:9], v[16:17]
    v_pk_add_f32 v[10:11], v[10:11], v[18:19]
    v_pk_add_f32 v[12:13], v[12:13], v[20:21]
    v_pk_add_f32 v[14:15], v[14:15], v[22:23]
    s_mul_i32 s42, s41, 1536
    s_mul_i32 s43, s40, 6
    s_add_u32 s42, s42, s43
    v_mul_u32_u24 v27, 24, v2
    v_add_u32 v27, s42, v27
    ds_read_u16 v24, v27 offset:13312
    ds_read_u16 v25, v27 offset:13314
    ds_read_u16 v26, v27 offset:13316
    s_mul_i32 s42, s40, 1536
    s_lshl_b32 s43, s41, 9
    s_add_u32 s42, s42, s43
    v_lshlrev_b32 v6, 5, v4
    v_lshl_add_u32 v6, v3, 3, v6
    v_add_u32 v6, s42, v6
    s_lshl_b32 s43, s41, 7
    v_lshlrev_b32 v7, 3, v4
    v_add_u32 v7, s43, v7
    v_subrev_u32 v27, 192, v7
    v_min_u32 v7, v7, v27
    v_lshlrev_b32 v7, 2, v7
    v_and_b32 v27, 1, v3
    v_lshrrev_b32 v31, 1, v3
    v_lshl_add_u32 v31, v27, 1, v31
    v_lshlrev_b32 v31, 2, v31
    s_lshl_b32 s42, s41, 6
    s_lshl_b32 s43, s40, 4
    s_add_u32 s42, s42, s43
    v_add_u32 v4, s42, v31
    s_lshl_b32 s42, s41, 8
    v_lshlrev_b32 v3, 2, v2
    v_add_u32 v3, s42, v3
    v_and_b32 v32, 48, v1
    v_lshrrev_b32 v33, 2, v2
    v_mul_u32_u24 v33, 20480, v33
    v_add_u32 v33, v33, v32
    s_waitcnt lgkmcnt(0)
    v_lshlrev_b32 v24, 16, v24
    v_lshlrev_b32 v25, 16, v25
    v_lshlrev_b32 v26, 16, v26
    v_mul_f32 v24, 0x36800000, v24
    v_mul_f32 v25, 0x36800000, v25
    v_mul_f32 v26, 0x36800000, v26
    s_waitcnt vmcnt(2)
    buffer_load_dwordx4 v[128:131], v5, s[16:19], s66 offen nt
    v_lshlrev_b32 v16, 16, v116
    v_and_b32 v17, s30, v116
    v_lshlrev_b32 v18, 16, v117
    v_and_b32 v19, s30, v117
    v_lshlrev_b32 v20, 16, v118
    v_and_b32 v21, s30, v118
    v_lshlrev_b32 v22, 16, v119
    v_and_b32 v23, s30, v119
    v_pk_add_f32 v[8:9], v[8:9], v[16:17]
    v_pk_add_f32 v[10:11], v[10:11], v[18:19]
    v_pk_add_f32 v[12:13], v[12:13], v[20:21]
    v_pk_add_f32 v[14:15], v[14:15], v[22:23]
    s_waitcnt vmcnt(2)
    buffer_load_dwordx4 v[132:135], v5, s[16:19], s67 offen nt
    v_lshlrev_b32 v16, 16, v120
    v_and_b32 v17, s30, v120
    v_lshlrev_b32 v18, 16, v121
    v_and_b32 v19, s30, v121
    v_lshlrev_b32 v20, 16, v122
    v_and_b32 v21, s30, v122
    v_lshlrev_b32 v22, 16, v123
    v_and_b32 v23, s30, v123
    v_pk_add_f32 v[8:9], v[8:9], v[16:17]
    v_pk_add_f32 v[10:11], v[10:11], v[18:19]
    v_pk_add_f32 v[12:13], v[12:13], v[20:21]
    v_pk_add_f32 v[14:15], v[14:15], v[22:23]
    s_waitcnt vmcnt(2)
    buffer_load_dwordx4 v[136:139], v5, s[16:19], s68 offen nt
    v_lshlrev_b32 v16, 16, v124
    v_and_b32 v17, s30, v124
    v_lshlrev_b32 v18, 16, v125
    v_and_b32 v19, s30, v125
    v_lshlrev_b32 v20, 16, v126
    v_and_b32 v21, s30, v126
    v_lshlrev_b32 v22, 16, v127
    v_and_b32 v23, s30, v127
    v_pk_add_f32 v[8:9], v[8:9], v[16:17]
    v_pk_add_f32 v[10:11], v[10:11], v[18:19]
    v_pk_add_f32 v[12:13], v[12:13], v[20:21]
    v_pk_add_f32 v[14:15], v[14:15], v[22:23]
    s_waitcnt vmcnt(2)
    buffer_load_dwordx4 v[140:143], v5, s[16:19], s69 offen nt
    v_lshlrev_b32 v16, 16, v128
    v_and_b32 v17, s30, v128
    v_lshlrev_b32 v18, 16, v129
    v_and_b32 v19, s30, v129
    v_lshlrev_b32 v20, 16, v130
    v_and_b32 v21, s30, v130
    v_lshlrev_b32 v22, 16, v131
    v_and_b32 v23, s30, v131
    v_pk_add_f32 v[8:9], v[8:9], v[16:17]
    v_pk_add_f32 v[10:11], v[10:11], v[18:19]
    v_pk_add_f32 v[12:13], v[12:13], v[20:21]
    v_pk_add_f32 v[14:15], v[14:15], v[22:23]
    s_waitcnt vmcnt(2)
    buffer_load_dwordx4 v[144:147], v5, s[16:19], s70 offen nt
    v_lshlrev_b32 v16, 16, v132
    v_and_b32 v17, s30, v132
    v_lshlrev_b32 v18, 16, v133
    v_and_b32 v19, s30, v133
    v_lshlrev_b32 v20, 16, v134
    v_and_b32 v21, s30, v134
    v_lshlrev_b32 v22, 16, v135
    v_and_b32 v23, s30, v135
    v_pk_add_f32 v[8:9], v[8:9], v[16:17]
    v_pk_add_f32 v[10:11], v[10:11], v[18:19]
    v_pk_add_f32 v[12:13], v[12:13], v[20:21]
    v_pk_add_f32 v[14:15], v[14:15], v[22:23]
    s_waitcnt vmcnt(2)
    buffer_load_dwordx4 v[148:151], v5, s[16:19], s71 offen nt
    v_lshlrev_b32 v16, 16, v136
    v_and_b32 v17, s30, v136
    v_lshlrev_b32 v18, 16, v137
    v_and_b32 v19, s30, v137
    v_lshlrev_b32 v20, 16, v138
    v_and_b32 v21, s30, v138
    v_lshlrev_b32 v22, 16, v139
    v_and_b32 v23, s30, v139
    v_pk_add_f32 v[8:9], v[8:9], v[16:17]
    v_pk_add_f32 v[10:11], v[10:11], v[18:19]
    v_pk_add_f32 v[12:13], v[12:13], v[20:21]
    v_pk_add_f32 v[14:15], v[14:15], v[22:23]
    s_waitcnt vmcnt(2)
    buffer_load_dwordx4 v[152:155], v5, s[16:19], s72 offen nt
    v_lshlrev_b32 v16, 16, v140
    v_and_b32 v17, s30, v140
    v_lshlrev_b32 v18, 16, v141
    v_and_b32 v19, s30, v141
    v_lshlrev_b32 v20, 16, v142
    v_and_b32 v21, s30, v142
    v_lshlrev_b32 v22, 16, v143
    v_and_b32 v23, s30, v143
    v_pk_add_f32 v[8:9], v[8:9], v[16:17]
    v_pk_add_f32 v[10:11], v[10:11], v[18:19]
    v_pk_add_f32 v[12:13], v[12:13], v[20:21]
    v_pk_add_f32 v[14:15], v[14:15], v[22:23]
    s_waitcnt vmcnt(2)
    buffer_load_dwordx4 v[156:159], v5, s[16:19], s73 offen nt
    v_lshlrev_b32 v16, 16, v144
    v_and_b32 v17, s30, v144
    v_lshlrev_b32 v18, 16, v145
    v_and_b32 v19, s30, v145
    v_lshlrev_b32 v20, 16, v146
    v_and_b32 v21, s30, v146
    v_lshlrev_b32 v22, 16, v147
    v_and_b32 v23, s30, v147
    v_pk_add_f32 v[8:9], v[8:9], v[16:17]
    v_pk_add_f32 v[10:11], v[10:11], v[18:19]
    v_pk_add_f32 v[12:13], v[12:13], v[20:21]
    v_pk_add_f32 v[14:15], v[14:15], v[22:23]
    s_waitcnt vmcnt(2)
    buffer_load_dwordx4 v[160:163], v5, s[16:19], s74 offen nt
    v_lshlrev_b32 v16, 16, v148
    v_and_b32 v17, s30, v148
    v_lshlrev_b32 v18, 16, v149
    v_and_b32 v19, s30, v149
    v_lshlrev_b32 v20, 16, v150
    v_and_b32 v21, s30, v150
    v_lshlrev_b32 v22, 16, v151
    v_and_b32 v23, s30, v151
    v_pk_add_f32 v[8:9], v[8:9], v[16:17]
    v_pk_add_f32 v[10:11], v[10:11], v[18:19]
    v_pk_add_f32 v[12:13], v[12:13], v[20:21]
    v_pk_add_f32 v[14:15], v[14:15], v[22:23]
    s_waitcnt vmcnt(2)
    buffer_load_dwordx4 v[164:167], v5, s[16:19], s75 offen nt
    v_lshlrev_b32 v16, 16, v152
    v_and_b32 v17, s30, v152
    v_lshlrev_b32 v18, 16, v153
    v_and_b32 v19, s30, v153
    v_lshlrev_b32 v20, 16, v154
    v_and_b32 v21, s30, v154
    v_lshlrev_b32 v22, 16, v155
    v_and_b32 v23, s30, v155
    v_pk_add_f32 v[8:9], v[8:9], v[16:17]
    v_pk_add_f32 v[10:11], v[10:11], v[18:19]
    v_pk_add_f32 v[12:13], v[12:13], v[20:21]
    v_pk_add_f32 v[14:15], v[14:15], v[22:23]
    s_waitcnt vmcnt(2)
    v_lshlrev_b32 v16, 16, v156
    v_and_b32 v17, s30, v156
    v_lshlrev_b32 v18, 16, v157
    v_and_b32 v19, s30, v157
    v_lshlrev_b32 v20, 16, v158
    v_and_b32 v21, s30, v158
    v_lshlrev_b32 v22, 16, v159
    v_and_b32 v23, s30, v159
    v_pk_add_f32 v[8:9], v[8:9], v[16:17]
    v_pk_add_f32 v[10:11], v[10:11], v[18:19]
    v_pk_add_f32 v[12:13], v[12:13], v[20:21]
    v_pk_add_f32 v[14:15], v[14:15], v[22:23]
    s_waitcnt vmcnt(1)
    v_lshlrev_b32 v16, 16, v160
    v_and_b32 v17, s30, v160
    v_lshlrev_b32 v18, 16, v161
    v_and_b32 v19, s30, v161
    v_lshlrev_b32 v20, 16, v162
    v_and_b32 v21, s30, v162
    v_lshlrev_b32 v22, 16, v163
    v_and_b32 v23, s30, v163
    v_pk_add_f32 v[8:9], v[8:9], v[16:17]
    v_pk_add_f32 v[10:11], v[10:11], v[18:19]
    v_pk_add_f32 v[12:13], v[12:13], v[20:21]
    v_pk_add_f32 v[14:15], v[14:15], v[22:23]
    s_waitcnt vmcnt(0)
    v_lshlrev_b32 v16, 16, v164
    v_and_b32 v17, s30, v164
    v_lshlrev_b32 v18, 16, v165
    v_and_b32 v19, s30, v165
    v_lshlrev_b32 v20, 16, v166
    v_and_b32 v21, s30, v166
    v_lshlrev_b32 v22, 16, v167
    v_and_b32 v23, s30, v167
    v_pk_add_f32 v[8:9], v[8:9], v[16:17]
    v_pk_add_f32 v[10:11], v[10:11], v[18:19]
    v_pk_add_f32 v[12:13], v[12:13], v[20:21]
    v_pk_add_f32 v[14:15], v[14:15], v[22:23]
    s_nop 1
    v_permlane32_swap_b32 v8, v12
    v_permlane32_swap_b32 v9, v13
    v_permlane32_swap_b32 v10, v14
    v_permlane32_swap_b32 v11, v15
    v_add_f32 v8, v8, v12
    v_add_f32 v9, v9, v13
    v_add_f32 v10, v10, v14
    v_add_f32 v11, v11, v15
    s_nop 0
    v_permlane16_swap_b32 v8, v10
    v_permlane16_swap_b32 v9, v11
    v_add_f32 v8, v8, v10
    v_add_f32 v9, v9, v11
    ds_write_b64 v6, v[8:9] offset:0
    s_waitcnt lgkmcnt(0)
    s_barrier
    ds_read2st64_b32 v[16:17], v3 offset0:0 offset1:3
    ds_read2st64_b32 v[18:19], v3 offset0:6 offset1:9
    ds_read2st64_b32 v[20:21], v3 offset0:12 offset1:15
    ds_read2st64_b32 v[22:23], v3 offset0:18 offset1:21
    s_waitcnt lgkmcnt(2)
    v_pk_add_f32 v[16:17], v[16:17], v[18:19]
    s_waitcnt lgkmcnt(0)
    v_pk_add_f32 v[20:21], v[20:21], v[22:23]
    v_pk_add_f32 v[16:17], v[16:17], v[20:21]
    v_add_f32 v16, v16, v17
    v_mul_f32 v10, v16, v26
    v_mul_f32 v11, v16, v26
    v_mul_f32 v8, v16, v24
    v_mul_f32 v9, v16, v25
    v_permlane32_swap_b32 v10, v11
    s_nop 0
    v_permlane32_swap_b32 v8, v9
    v_add_f32 v10, v10, v11
    v_add_f32 v8, v8, v9
    s_nop 1
    v_permlane16_swap_b32 v8, v10
    v_add_f32 v8, v8, v10
    s_nop 1
    v_add_f32_dpp v9, v8, v8 row_shr:1 row_mask:0xf bank_mask:0xf bound_ctrl:0
    s_nop 1
    v_add_f32_dpp v9, v9, v9 row_shr:2 row_mask:0xf bank_mask:0xf bound_ctrl:0
    s_nop 1
    v_add_f32_dpp v9, v9, v9 row_shr:4 row_mask:0xf bank_mask:0xf bound_ctrl:0
    s_nop 1
    v_add_f32_dpp v9, v9, v9 row_shr:8 row_mask:0xf bank_mask:0xf bound_ctrl:0
    s_mov_b32 exec_lo, 0x80008000
    s_mov_b32 exec_hi, 0x00008000
    ds_write_b32 v4, v9 offset:6144
    s_mov_b64 exec, -1
    s_lshl_b32 s42, s2, 6
    s_cmp_lg_u32 s3, 4
    s_waitcnt lgkmcnt(0)
    s_barrier
    s_cbranch_scc1 L_notpub
    s_mov_b32 exec_hi, 0
    ds_read_b128 v[8:11], v32 offset:6144
    ds_read_b128 v[12:15], v32 offset:6208
    ds_read_b128 v[16:19], v32 offset:6272
    s_waitcnt lgkmcnt(1)
    v_pk_add_f32 v[8:9], v[8:9], v[12:13]
    v_add_f32 v10, v10, v14
    s_waitcnt lgkmcnt(0)
    v_pk_add_f32 v[8:9], v[8:9], v[16:17]
    v_add_f32 v10, v10, v18
    v_bitop3_b32 v11, v8, v9, s29 bitop3:0x96
    v_xor_b32 v11, v11, v10
    buffer_store_dwordx4 v[8:11], v33, s[24:27], s42 offen sc1
    s_mov_b64 exec, -1
    s_barrier
    s_branch L_b3
L_notpub:
    s_barrier
    s_cmp_lt_u32 s3, 4
    s_cbranch_scc1 L_poll_start
    s_cmp_gt_u32 s3, 7
    s_cbranch_scc1 L_poll_start
    v_subrev_u32 v1, 320, v0
    v_lshlrev_b32 v21, 2, v1
    v_lshlrev_b32 v1, 1, v1
    ds_read_u16 v8, v1 offset:8192
    ds_read_u16 v9, v1 offset:8576
    ds_read_u16 v10, v1 offset:8960
    ds_read_u16 v11, v1 offset:9344
    ds_read_u16 v12, v1 offset:9728
    ds_read_u16 v13, v1 offset:10112
    ds_read_u16 v14, v1 offset:10496
    ds_read_u16 v15, v1 offset:10880
    ds_read_u16 v16, v1 offset:11264
    ds_read_u16 v17, v1 offset:11648
    ds_read_u16 v18, v1 offset:12032
    ds_read_u16 v19, v1 offset:12416
    v_and_b32 v20, 15, v2
    v_lshlrev_b32 v20, 2, v20
    v_add_u32 v20, 7488, v20
    s_waitcnt lgkmcnt(0)
    v_lshlrev_b32 v8, 16, v8
    v_lshlrev_b32 v9, 16, v9
    v_lshlrev_b32 v10, 16, v10
    v_lshlrev_b32 v11, 16, v11
    v_lshlrev_b32 v12, 16, v12
    v_lshlrev_b32 v13, 16, v13
    v_lshlrev_b32 v14, 16, v14
    v_lshlrev_b32 v15, 16, v15
    v_lshlrev_b32 v16, 16, v16
    v_lshlrev_b32 v17, 16, v17
    v_lshlrev_b32 v18, 16, v18
    v_lshlrev_b32 v19, 16, v19
    s_barrier
    ds_read2_b32 v[22:23], v20 offset0:0 offset1:16
    ds_read2_b32 v[24:25], v20 offset0:32 offset1:48
    ds_read2_b32 v[26:27], v20 offset0:64 offset1:80
    ds_read2_b32 v[28:29], v20 offset0:96 offset1:112
    s_waitcnt lgkmcnt(2)
    v_pk_add_f32 v[22:23], v[22:23], v[24:25]
    s_waitcnt lgkmcnt(0)
    v_pk_add_f32 v[24:25], v[26:27], v[28:29]
    v_pk_add_f32 v[22:23], v[22:23], v[24:25]
    v_add_f32 v22, v22, v23
    v_cvt_pk_bf16_f32 v22, 0, v22
    v_mul_f32 v23, 0xbfb8aa3b, v22
    v_exp_f32 v23, v23
    s_nop 0
    v_add_f32 v23, 1.0, v23
    v_rcp_f32 v23, v23
    s_nop 0
    v_mul_f32 v22, v22, v23
    v_cvt_pk_bf16_f32 v22, 0, v22
    s_nop 1
    v_mul_f32_dpp v23, v22, v8 row_newbcast:0 row_mask:0xf bank_mask:0xf
    v_mul_f32_dpp v24, v22, v9 row_newbcast:1 row_mask:0xf bank_mask:0xf
    v_mul_f32_dpp v25, v22, v10 row_newbcast:2 row_mask:0xf bank_mask:0xf
    v_fmac_f32_dpp v23, v22, v11 row_newbcast:3 row_mask:0xf bank_mask:0xf
    v_fmac_f32_dpp v24, v22, v12 row_newbcast:4 row_mask:0xf bank_mask:0xf
    v_fmac_f32_dpp v25, v22, v13 row_newbcast:5 row_mask:0xf bank_mask:0xf
    v_fmac_f32_dpp v23, v22, v14 row_newbcast:6 row_mask:0xf bank_mask:0xf
    v_fmac_f32_dpp v24, v22, v15 row_newbcast:7 row_mask:0xf bank_mask:0xf
    v_fmac_f32_dpp v25, v22, v16 row_newbcast:8 row_mask:0xf bank_mask:0xf
    v_fmac_f32_dpp v23, v22, v17 row_newbcast:9 row_mask:0xf bank_mask:0xf
    v_fmac_f32_dpp v24, v22, v18 row_newbcast:10 row_mask:0xf bank_mask:0xf
    v_fmac_f32_dpp v25, v22, v19 row_newbcast:11 row_mask:0xf bank_mask:0xf
    v_add_f32 v23, v23, v24
    v_add_f32 v23, v23, v25
    v_cvt_pk_bf16_f32 v23, 0, v23
    v_mul_f32 v23, 0xbfb8aa3b, v23
    v_exp_f32 v23, v23
    s_nop 0
    v_add_f32 v23, 1.0, v23
    v_rcp_f32 v23, v23
    s_nop 0
    v_cvt_pk_bf16_f32 v23, 0, v23
    ds_write_b32 v21, v23 offset:6656
    s_waitcnt lgkmcnt(0)
    s_barrier
    s_branch L_b5
L_poll_start:
    s_sub_u32 s10, s3, 4
    s_cmp_lt_u32 s3, 4
    s_cselect_b32 s10, s3, s10
    s_lshl_b32 s42, s10, 11
    s_getreg_b32 s43, hwreg(HW_REG_XCC_ID)
    s_and_b32 s43, s43, 7
    s_mul_i32 s43, s43, 20480
    s_add_u32 s42, s42, s43
    v_and_b32 v27, 3, v2
    v_mul_u32_u24 v27, 12, v27
    s_lshl_b32 s43, s10, 6
    v_add3_u32 v31, v31, v27, s43
    s_mov_b64 s[4:5], -1
    s_mov_b64 s[6:7], -1
    s_mov_b32 s31, 4000000
L_poll:
    s_mov_b64 exec, s[4:5]
    s_cbranch_execz L_skip0
    buffer_load_dwordx4 v[8:11], v1, s[24:27], s42 offen offset:0 sc1
L_skip0:
    s_mov_b64 exec, s[6:7]
    s_cbranch_execz L_skip1
    buffer_load_dwordx4 v[12:15], v1, s[24:27], s42 offen offset:1024 sc1
L_skip1:
    s_mov_b64 exec, -1
    s_waitcnt vmcnt(0)
    v_bitop3_b32 v27, v8, v9, s29 bitop3:0x96
    v_bitop3_b32 v28, v12, v13, s29 bitop3:0x96
    v_bitop3_b32 v27, v27, v10, v11 bitop3:0x96
    v_bitop3_b32 v28, v28, v14, v15 bitop3:0x96
    v_cmp_ne_u32 s[4:5], 0, v27
    v_cmp_ne_u32 s[6:7], 0, v28
    s_or_b64 s[82:83], s[4:5], s[6:7]
    s_cbranch_scc0 L_poll_ok
    s_sub_u32 s31, s31, 1
    s_cbranch_scc1 L_poll_ok
    s_branch L_poll
L_poll_ok:
    v_add_f32 v11, v10, v14
    v_add_f32 v10, v10, v14
    v_pk_add_f32 v[8:9], v[8:9], v[12:13]
    s_nop 0
    v_permlane32_swap_b32 v10, v11
    v_permlane32_swap_b32 v8, v9
    v_add_f32 v10, v10, v11
    v_add_f32 v8, v8, v9
    s_nop 1
    v_permlane16_swap_b32 v8, v10
    v_add_f32 v8, v8, v10
    s_nop 1
    v_add_f32_dpp v8, v8, v8 row_shr:4 row_mask:0xf bank_mask:0xf bound_ctrl:0
    s_nop 1
    v_add_f32_dpp v8, v8, v8 row_shr:8 row_mask:0xf bank_mask:0xf bound_ctrl:0
    s_mov_b32 exec_lo, 0xf000f000
    s_mov_b32 exec_hi, 0x0000f000
    ds_write_b32 v31, v8 offset:7488
    s_mov_b64 exec, -1
    s_waitcnt lgkmcnt(0)
    s_barrier
    s_branch L_b4
L_stub:
    s_branch L_stub2
.p2align 12
L_stub2:
    s_branch L_stubret
L_b3:
    s_barrier
L_b4:
    s_barrier
L_b5:
    ds_read_b128 v[8:11], v7 offset:6656
    ds_read_b128 v[12:15], v7 offset:6672
    v_lshlrev_b32 v16, 16, v40
    v_and_b32 v17, s30, v40
    v_lshlrev_b32 v18, 16, v41
    v_and_b32 v19, s30, v41
    v_lshlrev_b32 v20, 16, v42
    v_and_b32 v21, s30, v42
    v_lshlrev_b32 v22, 16, v43
    v_and_b32 v23, s30, v43
    s_waitcnt lgkmcnt(0)
    v_pk_mul_f32 v[16:17], v[16:17], v[8:9]
    v_pk_mul_f32 v[18:19], v[18:19], v[10:11]
    v_pk_mul_f32 v[20:21], v[20:21], v[12:13]
    v_pk_mul_f32 v[22:23], v[22:23], v[14:15]
    v_cvt_pk_bf16_f32 v40, v16, v17
    v_cvt_pk_bf16_f32 v41, v18, v19
    v_cvt_pk_bf16_f32 v42, v20, v21
    v_cvt_pk_bf16_f32 v43, v22, v23
    buffer_store_dwordx4 v[40:43], v5, s[20:23], s44 offen sc0 sc1
    s_barrier
    v_lshlrev_b32 v24, 16, v104
    v_and_b32 v25, s30, v104
    v_lshlrev_b32 v26, 16, v105
    v_and_b32 v27, s30, v105
    v_lshlrev_b32 v28, 16, v106
    v_and_b32 v29, s30, v106
    v_lshlrev_b32 v30, 16, v107
    v_and_b32 v31, s30, v107
    v_pk_mul_f32 v[24:25], v[24:25], v[8:9]
    v_pk_mul_f32 v[26:27], v[26:27], v[10:11]
    v_pk_mul_f32 v[28:29], v[28:29], v[12:13]
    v_pk_mul_f32 v[30:31], v[30:31], v[14:15]
    v_cvt_pk_bf16_f32 v104, v24, v25
    v_cvt_pk_bf16_f32 v105, v26, v27
    v_cvt_pk_bf16_f32 v106, v28, v29
    v_cvt_pk_bf16_f32 v107, v30, v31
    buffer_store_dwordx4 v[104:107], v5, s[20:23], s60 offen sc0 sc1
    s_cmp_lg_u32 s2, 0
    s_cbranch_scc1 L_noep
    s_cmp_lg_u32 s3, 11
    s_cbranch_scc1 L_noep
    v_mov_b32 v1, 401408
    v_mov_b32 v3, s28
    s_mov_b64 exec, 1
    buffer_store_dword v3, v1, s[24:27], 0 offen sc1
    s_mov_b64 exec, -1
L_noep:
    s_barrier
    v_lshlrev_b32 v16, 16, v44
    v_and_b32 v17, s30, v44
    v_lshlrev_b32 v18, 16, v45
    v_and_b32 v19, s30, v45
    v_lshlrev_b32 v20, 16, v46
    v_and_b32 v21, s30, v46
    v_lshlrev_b32 v22, 16, v47
    v_and_b32 v23, s30, v47
    v_pk_mul_f32 v[16:17], v[16:17], v[8:9]
    v_pk_mul_f32 v[18:19], v[18:19], v[10:11]
    v_pk_mul_f32 v[20:21], v[20:21], v[12:13]
    v_pk_mul_f32 v[22:23], v[22:23], v[14:15]
    v_cvt_pk_bf16_f32 v44, v16, v17
    v_cvt_pk_bf16_f32 v45, v18, v19
    v_cvt_pk_bf16_f32 v46, v20, v21
    v_cvt_pk_bf16_f32 v47, v22, v23
    buffer_store_dwordx4 v[44:47], v5, s[20:23], s45 offen sc0 sc1
    s_barrier
    v_lshlrev_b32 v24, 16, v108
    v_and_b32 v25, s30, v108
    v_lshlrev_b32 v26, 16, v109
    v_and_b32 v27, s30, v109
    v_lshlrev_b32 v28, 16, v110
    v_and_b32 v29, s30, v110
    v_lshlrev_b32 v30, 16, v111
    v_and_b32 v31, s30, v111
    v_pk_mul_f32 v[24:25], v[24:25], v[8:9]
    v_pk_mul_f32 v[26:27], v[26:27], v[10:11]
    v_pk_mul_f32 v[28:29], v[28:29], v[12:13]
    v_pk_mul_f32 v[30:31], v[30:31], v[14:15]
    v_cvt_pk_bf16_f32 v108, v24, v25
    v_cvt_pk_bf16_f32 v109, v26, v27
    v_cvt_pk_bf16_f32 v110, v28, v29
    v_cvt_pk_bf16_f32 v111, v30, v31
    buffer_store_dwordx4 v[108:111], v5, s[20:23], s61 offen sc0 sc1
    s_barrier
    v_lshlrev_b32 v16, 16, v48
    v_and_b32 v17, s30, v48
    v_lshlrev_b32 v18, 16, v49
    v_and_b32 v19, s30, v49
    v_lshlrev_b32 v20, 16, v50
    v_and_b32 v21, s30, v50
    v_lshlrev_b32 v22, 16, v51
    v_and_b32 v23, s30, v51
    v_pk_mul_f32 v[16:17], v[16:17], v[8:9]
    v_pk_mul_f32 v[18:19], v[18:19], v[10:11]
    v_pk_mul_f32 v[20:21], v[20:21], v[12:13]
    v_pk_mul_f32 v[22:23], v[22:23], v[14:15]
    v_cvt_pk_bf16_f32 v48, v16, v17
    v_cvt_pk_bf16_f32 v49, v18, v19
    v_cvt_pk_bf16_f32 v50, v20, v21
    v_cvt_pk_bf16_f32 v51, v22, v23
    buffer_store_dwordx4 v[48:51], v5, s[20:23], s46 offen sc0 sc1
    s_barrier
    v_lshlrev_b32 v24, 16, v112
    v_and_b32 v25, s30, v112
    v_lshlrev_b32 v26, 16, v113
    v_and_b32 v27, s30, v113
    v_lshlrev_b32 v28, 16, v114
    v_and_b32 v29, s30, v114
    v_lshlrev_b32 v30, 16, v115
    v_and_b32 v31, s30, v115
    v_pk_mul_f32 v[24:25], v[24:25], v[8:9]
    v_pk_mul_f32 v[26:27], v[26:27], v[10:11]
    v_pk_mul_f32 v[28:29], v[28:29], v[12:13]
    v_pk_mul_f32 v[30:31], v[30:31], v[14:15]
    v_cvt_pk_bf16_f32 v112, v24, v25
    v_cvt_pk_bf16_f32 v113, v26, v27
    v_cvt_pk_bf16_f32 v114, v28, v29
    v_cvt_pk_bf16_f32 v115, v30, v31
    buffer_store_dwordx4 v[112:115], v5, s[20:23], s62 offen sc0 sc1
    s_barrier
    v_lshlrev_b32 v16, 16, v52
    v_and_b32 v17, s30, v52
    v_lshlrev_b32 v18, 16, v53
    v_and_b32 v19, s30, v53
    v_lshlrev_b32 v20, 16, v54
    v_and_b32 v21, s30, v54
    v_lshlrev_b32 v22, 16, v55
    v_and_b32 v23, s30, v55
    v_pk_mul_f32 v[16:17], v[16:17], v[8:9]
    v_pk_mul_f32 v[18:19], v[18:19], v[10:11]
    v_pk_mul_f32 v[20:21], v[20:21], v[12:13]
    v_pk_mul_f32 v[22:23], v[22:23], v[14:15]
    v_cvt_pk_bf16_f32 v52, v16, v17
    v_cvt_pk_bf16_f32 v53, v18, v19
    v_cvt_pk_bf16_f32 v54, v20, v21
    v_cvt_pk_bf16_f32 v55, v22, v23
    buffer_store_dwordx4 v[52:55], v5, s[20:23], s47 offen sc0 sc1
    s_barrier
    v_lshlrev_b32 v24, 16, v116
    v_and_b32 v25, s30, v116
    v_lshlrev_b32 v26, 16, v117
    v_and_b32 v27, s30, v117
    v_lshlrev_b32 v28, 16, v118
    v_and_b32 v29, s30, v118
    v_lshlrev_b32 v30, 16, v119
    v_and_b32 v31, s30, v119
    v_pk_mul_f32 v[24:25], v[24:25], v[8:9]
    v_pk_mul_f32 v[26:27], v[26:27], v[10:11]
    v_pk_mul_f32 v[28:29], v[28:29], v[12:13]
    v_pk_mul_f32 v[30:31], v[30:31], v[14:15]
    v_cvt_pk_bf16_f32 v116, v24, v25
    v_cvt_pk_bf16_f32 v117, v26, v27
    v_cvt_pk_bf16_f32 v118, v28, v29
    v_cvt_pk_bf16_f32 v119, v30, v31
    buffer_store_dwordx4 v[116:119], v5, s[20:23], s63 offen sc0 sc1
    s_barrier
    v_lshlrev_b32 v16, 16, v56
    v_and_b32 v17, s30, v56
    v_lshlrev_b32 v18, 16, v57
    v_and_b32 v19, s30, v57
    v_lshlrev_b32 v20, 16, v58
    v_and_b32 v21, s30, v58
    v_lshlrev_b32 v22, 16, v59
    v_and_b32 v23, s30, v59
    v_pk_mul_f32 v[16:17], v[16:17], v[8:9]
    v_pk_mul_f32 v[18:19], v[18:19], v[10:11]
    v_pk_mul_f32 v[20:21], v[20:21], v[12:13]
    v_pk_mul_f32 v[22:23], v[22:23], v[14:15]
    v_cvt_pk_bf16_f32 v56, v16, v17
    v_cvt_pk_bf16_f32 v57, v18, v19
    v_cvt_pk_bf16_f32 v58, v20, v21
    v_cvt_pk_bf16_f32 v59, v22, v23
    buffer_store_dwordx4 v[56:59], v5, s[20:23], s48 offen sc0 sc1
    s_barrier
    v_lshlrev_b32 v24, 16, v120
    v_and_b32 v25, s30, v120
    v_lshlrev_b32 v26, 16, v121
    v_and_b32 v27, s30, v121
    v_lshlrev_b32 v28, 16, v122
    v_and_b32 v29, s30, v122
    v_lshlrev_b32 v30, 16, v123
    v_and_b32 v31, s30, v123
    v_pk_mul_f32 v[24:25], v[24:25], v[8:9]
    v_pk_mul_f32 v[26:27], v[26:27], v[10:11]
    v_pk_mul_f32 v[28:29], v[28:29], v[12:13]
    v_pk_mul_f32 v[30:31], v[30:31], v[14:15]
    v_cvt_pk_bf16_f32 v120, v24, v25
    v_cvt_pk_bf16_f32 v121, v26, v27
    v_cvt_pk_bf16_f32 v122, v28, v29
    v_cvt_pk_bf16_f32 v123, v30, v31
    buffer_store_dwordx4 v[120:123], v5, s[20:23], s64 offen sc0 sc1
    s_barrier
    v_lshlrev_b32 v16, 16, v60
    v_and_b32 v17, s30, v60
    v_lshlrev_b32 v18, 16, v61
    v_and_b32 v19, s30, v61
    v_lshlrev_b32 v20, 16, v62
    v_and_b32 v21, s30, v62
    v_lshlrev_b32 v22, 16, v63
    v_and_b32 v23, s30, v63
    v_pk_mul_f32 v[16:17], v[16:17], v[8:9]
    v_pk_mul_f32 v[18:19], v[18:19], v[10:11]
    v_pk_mul_f32 v[20:21], v[20:21], v[12:13]
    v_pk_mul_f32 v[22:23], v[22:23], v[14:15]
    v_cvt_pk_bf16_f32 v60, v16, v17
    v_cvt_pk_bf16_f32 v61, v18, v19
    v_cvt_pk_bf16_f32 v62, v20, v21
    v_cvt_pk_bf16_f32 v63, v22, v23
    buffer_store_dwordx4 v[60:63], v5, s[20:23], s49 offen sc0 sc1
    s_barrier
    v_lshlrev_b32 v24, 16, v124
    v_and_b32 v25, s30, v124
    v_lshlrev_b32 v26, 16, v125
    v_and_b32 v27, s30, v125
    v_lshlrev_b32 v28, 16, v126
    v_and_b32 v29, s30, v126
    v_lshlrev_b32 v30, 16, v127
    v_and_b32 v31, s30, v127
    v_pk_mul_f32 v[24:25], v[24:25], v[8:9]
    v_pk_mul_f32 v[26:27], v[26:27], v[10:11]
    v_pk_mul_f32 v[28:29], v[28:29], v[12:13]
    v_pk_mul_f32 v[30:31], v[30:31], v[14:15]
    v_cvt_pk_bf16_f32 v124, v24, v25
    v_cvt_pk_bf16_f32 v125, v26, v27
    v_cvt_pk_bf16_f32 v126, v28, v29
    v_cvt_pk_bf16_f32 v127, v30, v31
    buffer_store_dwordx4 v[124:127], v5, s[20:23], s65 offen sc0 sc1
    s_barrier
    v_lshlrev_b32 v16, 16, v64
    v_and_b32 v17, s30, v64
    v_lshlrev_b32 v18, 16, v65
    v_and_b32 v19, s30, v65
    v_lshlrev_b32 v20, 16, v66
    v_and_b32 v21, s30, v66
    v_lshlrev_b32 v22, 16, v67
    v_and_b32 v23, s30, v67
    v_pk_mul_f32 v[16:17], v[16:17], v[8:9]
    v_pk_mul_f32 v[18:19], v[18:19], v[10:11]
    v_pk_mul_f32 v[20:21], v[20:21], v[12:13]
    v_pk_mul_f32 v[22:23], v[22:23], v[14:15]
    v_cvt_pk_bf16_f32 v64, v16, v17
    v_cvt_pk_bf16_f32 v65, v18, v19
    v_cvt_pk_bf16_f32 v66, v20, v21
    v_cvt_pk_bf16_f32 v67, v22, v23
    buffer_store_dwordx4 v[64:67], v5, s[20:23], s50 offen sc0 sc1
    s_barrier
    v_lshlrev_b32 v24, 16, v128
    v_and_b32 v25, s30, v128
    v_lshlrev_b32 v26, 16, v129
    v_and_b32 v27, s30, v129
    v_lshlrev_b32 v28, 16, v130
    v_and_b32 v29, s30, v130
    v_lshlrev_b32 v30, 16, v131
    v_and_b32 v31, s30, v131
    v_pk_mul_f32 v[24:25], v[24:25], v[8:9]
    v_pk_mul_f32 v[26:27], v[26:27], v[10:11]
    v_pk_mul_f32 v[28:29], v[28:29], v[12:13]
    v_pk_mul_f32 v[30:31], v[30:31], v[14:15]
    v_cvt_pk_bf16_f32 v128, v24, v25
    v_cvt_pk_bf16_f32 v129, v26, v27
    v_cvt_pk_bf16_f32 v130, v28, v29
    v_cvt_pk_bf16_f32 v131, v30, v31
    buffer_store_dwordx4 v[128:131], v5, s[20:23], s66 offen sc0 sc1
    s_barrier
    v_lshlrev_b32 v16, 16, v68
    v_and_b32 v17, s30, v68
    v_lshlrev_b32 v18, 16, v69
    v_and_b32 v19, s30, v69
    v_lshlrev_b32 v20, 16, v70
    v_and_b32 v21, s30, v70
    v_lshlrev_b32 v22, 16, v71
    v_and_b32 v23, s30, v71
    v_pk_mul_f32 v[16:17], v[16:17], v[8:9]
    v_pk_mul_f32 v[18:19], v[18:19], v[10:11]
    v_pk_mul_f32 v[20:21], v[20:21], v[12:13]
    v_pk_mul_f32 v[22:23], v[22:23], v[14:15]
    v_cvt_pk_bf16_f32 v68, v16, v17
    v_cvt_pk_bf16_f32 v69, v18, v19
    v_cvt_pk_bf16_f32 v70, v20, v21
    v_cvt_pk_bf16_f32 v71, v22, v23
    buffer_store_dwordx4 v[68:71], v5, s[20:23], s51 offen sc0 sc1
    s_barrier
    v_lshlrev_b32 v24, 16, v132
    v_and_b32 v25, s30, v132
    v_lshlrev_b32 v26, 16, v133
    v_and_b32 v27, s30, v133
    v_lshlrev_b32 v28, 16, v134
    v_and_b32 v29, s30, v134
    v_lshlrev_b32 v30, 16, v135
    v_and_b32 v31, s30, v135
    v_pk_mul_f32 v[24:25], v[24:25], v[8:9]
    v_pk_mul_f32 v[26:27], v[26:27], v[10:11]
    v_pk_mul_f32 v[28:29], v[28:29], v[12:13]
    v_pk_mul_f32 v[30:31], v[30:31], v[14:15]
    v_cvt_pk_bf16_f32 v132, v24, v25
    v_cvt_pk_bf16_f32 v133, v26, v27
    v_cvt_pk_bf16_f32 v134, v28, v29
    v_cvt_pk_bf16_f32 v135, v30, v31
    buffer_store_dwordx4 v[132:135], v5, s[20:23], s67 offen sc0 sc1
    s_barrier
    v_lshlrev_b32 v16, 16, v72
    v_and_b32 v17, s30, v72
    v_lshlrev_b32 v18, 16, v73
    v_and_b32 v19, s30, v73
    v_lshlrev_b32 v20, 16, v74
    v_and_b32 v21, s30, v74
    v_lshlrev_b32 v22, 16, v75
    v_and_b32 v23, s30, v75
    v_pk_mul_f32 v[16:17], v[16:17], v[8:9]
    v_pk_mul_f32 v[18:19], v[18:19], v[10:11]
    v_pk_mul_f32 v[20:21], v[20:21], v[12:13]
    v_pk_mul_f32 v[22:23], v[22:23], v[14:15]
    v_cvt_pk_bf16_f32 v72, v16, v17
    v_cvt_pk_bf16_f32 v73, v18, v19
    v_cvt_pk_bf16_f32 v74, v20, v21
    v_cvt_pk_bf16_f32 v75, v22, v23
    buffer_store_dwordx4 v[72:75], v5, s[20:23], s52 offen sc0 sc1
    s_barrier
    v_lshlrev_b32 v24, 16, v136
    v_and_b32 v25, s30, v136
    v_lshlrev_b32 v26, 16, v137
    v_and_b32 v27, s30, v137
    v_lshlrev_b32 v28, 16, v138
    v_and_b32 v29, s30, v138
    v_lshlrev_b32 v30, 16, v139
    v_and_b32 v31, s30, v139
    v_pk_mul_f32 v[24:25], v[24:25], v[8:9]
    v_pk_mul_f32 v[26:27], v[26:27], v[10:11]
    v_pk_mul_f32 v[28:29], v[28:29], v[12:13]
    v_pk_mul_f32 v[30:31], v[30:31], v[14:15]
    v_cvt_pk_bf16_f32 v136, v24, v25
    v_cvt_pk_bf16_f32 v137, v26, v27
    v_cvt_pk_bf16_f32 v138, v28, v29
    v_cvt_pk_bf16_f32 v139, v30, v31
    buffer_store_dwordx4 v[136:139], v5, s[20:23], s68 offen sc0 sc1
    s_barrier
    v_lshlrev_b32 v16, 16, v76
    v_and_b32 v17, s30, v76
    v_lshlrev_b32 v18, 16, v77
    v_and_b32 v19, s30, v77
    v_lshlrev_b32 v20, 16, v78
    v_and_b32 v21, s30, v78
    v_lshlrev_b32 v22, 16, v79
    v_and_b32 v23, s30, v79
    v_pk_mul_f32 v[16:17], v[16:17], v[8:9]
    v_pk_mul_f32 v[18:19], v[18:19], v[10:11]
    v_pk_mul_f32 v[20:21], v[20:21], v[12:13]
    v_pk_mul_f32 v[22:23], v[22:23], v[14:15]
    v_cvt_pk_bf16_f32 v76, v16, v17
    v_cvt_pk_bf16_f32 v77, v18, v19
    v_cvt_pk_bf16_f32 v78, v20, v21
    v_cvt_pk_bf16_f32 v79, v22, v23
    buffer_store_dwordx4 v[76:79], v5, s[20:23], s53 offen sc0 sc1
    s_barrier
    v_lshlrev_b32 v24, 16, v140
    v_and_b32 v25, s30, v140
    v_lshlrev_b32 v26, 16, v141
    v_and_b32 v27, s30, v141
    v_lshlrev_b32 v28, 16, v142
    v_and_b32 v29, s30, v142
    v_lshlrev_b32 v30, 16, v143
    v_and_b32 v31, s30, v143
    v_pk_mul_f32 v[24:25], v[24:25], v[8:9]
    v_pk_mul_f32 v[26:27], v[26:27], v[10:11]
    v_pk_mul_f32 v[28:29], v[28:29], v[12:13]
    v_pk_mul_f32 v[30:31], v[30:31], v[14:15]
    v_cvt_pk_bf16_f32 v140, v24, v25
    v_cvt_pk_bf16_f32 v141, v26, v27
    v_cvt_pk_bf16_f32 v142, v28, v29
    v_cvt_pk_bf16_f32 v143, v30, v31
    buffer_store_dwordx4 v[140:143], v5, s[20:23], s69 offen sc0 sc1
    s_barrier
    v_lshlrev_b32 v16, 16, v80
    v_and_b32 v17, s30, v80
    v_lshlrev_b32 v18, 16, v81
    v_and_b32 v19, s30, v81
    v_lshlrev_b32 v20, 16, v82
    v_and_b32 v21, s30, v82
    v_lshlrev_b32 v22, 16, v83
    v_and_b32 v23, s30, v83
    v_pk_mul_f32 v[16:17], v[16:17], v[8:9]
    v_pk_mul_f32 v[18:19], v[18:19], v[10:11]
    v_pk_mul_f32 v[20:21], v[20:21], v[12:13]
    v_pk_mul_f32 v[22:23], v[22:23], v[14:15]
    v_cvt_pk_bf16_f32 v80, v16, v17
    v_cvt_pk_bf16_f32 v81, v18, v19
    v_cvt_pk_bf16_f32 v82, v20, v21
    v_cvt_pk_bf16_f32 v83, v22, v23
    buffer_store_dwordx4 v[80:83], v5, s[20:23], s54 offen sc0 sc1
    s_barrier
    v_lshlrev_b32 v24, 16, v144
    v_and_b32 v25, s30, v144
    v_lshlrev_b32 v26, 16, v145
    v_and_b32 v27, s30, v145
    v_lshlrev_b32 v28, 16, v146
    v_and_b32 v29, s30, v146
    v_lshlrev_b32 v30, 16, v147
    v_and_b32 v31, s30, v147
    v_pk_mul_f32 v[24:25], v[24:25], v[8:9]
    v_pk_mul_f32 v[26:27], v[26:27], v[10:11]
    v_pk_mul_f32 v[28:29], v[28:29], v[12:13]
    v_pk_mul_f32 v[30:31], v[30:31], v[14:15]
    v_cvt_pk_bf16_f32 v144, v24, v25
    v_cvt_pk_bf16_f32 v145, v26, v27
    v_cvt_pk_bf16_f32 v146, v28, v29
    v_cvt_pk_bf16_f32 v147, v30, v31
    buffer_store_dwordx4 v[144:147], v5, s[20:23], s70 offen sc0 sc1
    s_barrier
    v_lshlrev_b32 v16, 16, v84
    v_and_b32 v17, s30, v84
    v_lshlrev_b32 v18, 16, v85
    v_and_b32 v19, s30, v85
    v_lshlrev_b32 v20, 16, v86
    v_and_b32 v21, s30, v86
    v_lshlrev_b32 v22, 16, v87
    v_and_b32 v23, s30, v87
    v_pk_mul_f32 v[16:17], v[16:17], v[8:9]
    v_pk_mul_f32 v[18:19], v[18:19], v[10:11]
    v_pk_mul_f32 v[20:21], v[20:21], v[12:13]
    v_pk_mul_f32 v[22:23], v[22:23], v[14:15]
    v_cvt_pk_bf16_f32 v84, v16, v17
    v_cvt_pk_bf16_f32 v85, v18, v19
    v_cvt_pk_bf16_f32 v86, v20, v21
    v_cvt_pk_bf16_f32 v87, v22, v23
    buffer_store_dwordx4 v[84:87], v5, s[20:23], s55 offen sc0 sc1
    s_barrier
    v_lshlrev_b32 v24, 16, v148
    v_and_b32 v25, s30, v148
    v_lshlrev_b32 v26, 16, v149
    v_and_b32 v27, s30, v149
    v_lshlrev_b32 v28, 16, v150
    v_and_b32 v29, s30, v150
    v_lshlrev_b32 v30, 16, v151
    v_and_b32 v31, s30, v151
    v_pk_mul_f32 v[24:25], v[24:25], v[8:9]
    v_pk_mul_f32 v[26:27], v[26:27], v[10:11]
    v_pk_mul_f32 v[28:29], v[28:29], v[12:13]
    v_pk_mul_f32 v[30:31], v[30:31], v[14:15]
    v_cvt_pk_bf16_f32 v148, v24, v25
    v_cvt_pk_bf16_f32 v149, v26, v27
    v_cvt_pk_bf16_f32 v150, v28, v29
    v_cvt_pk_bf16_f32 v151, v30, v31
    buffer_store_dwordx4 v[148:151], v5, s[20:23], s71 offen sc0 sc1
    s_barrier
    v_lshlrev_b32 v16, 16, v88
    v_and_b32 v17, s30, v88
    v_lshlrev_b32 v18, 16, v89
    v_and_b32 v19, s30, v89
    v_lshlrev_b32 v20, 16, v90
    v_and_b32 v21, s30, v90
    v_lshlrev_b32 v22, 16, v91
    v_and_b32 v23, s30, v91
    v_pk_mul_f32 v[16:17], v[16:17], v[8:9]
    v_pk_mul_f32 v[18:19], v[18:19], v[10:11]
    v_pk_mul_f32 v[20:21], v[20:21], v[12:13]
    v_pk_mul_f32 v[22:23], v[22:23], v[14:15]
    v_cvt_pk_bf16_f32 v88, v16, v17
    v_cvt_pk_bf16_f32 v89, v18, v19
    v_cvt_pk_bf16_f32 v90, v20, v21
    v_cvt_pk_bf16_f32 v91, v22, v23
    buffer_store_dwordx4 v[88:91], v5, s[20:23], s56 offen sc0 sc1
    s_barrier
    v_lshlrev_b32 v24, 16, v152
    v_and_b32 v25, s30, v152
    v_lshlrev_b32 v26, 16, v153
    v_and_b32 v27, s30, v153
    v_lshlrev_b32 v28, 16, v154
    v_and_b32 v29, s30, v154
    v_lshlrev_b32 v30, 16, v155
    v_and_b32 v31, s30, v155
    v_pk_mul_f32 v[24:25], v[24:25], v[8:9]
    v_pk_mul_f32 v[26:27], v[26:27], v[10:11]
    v_pk_mul_f32 v[28:29], v[28:29], v[12:13]
    v_pk_mul_f32 v[30:31], v[30:31], v[14:15]
    v_cvt_pk_bf16_f32 v152, v24, v25
    v_cvt_pk_bf16_f32 v153, v26, v27
    v_cvt_pk_bf16_f32 v154, v28, v29
    v_cvt_pk_bf16_f32 v155, v30, v31
    buffer_store_dwordx4 v[152:155], v5, s[20:23], s72 offen sc0 sc1
    s_barrier
    v_lshlrev_b32 v16, 16, v92
    v_and_b32 v17, s30, v92
    v_lshlrev_b32 v18, 16, v93
    v_and_b32 v19, s30, v93
    v_lshlrev_b32 v20, 16, v94
    v_and_b32 v21, s30, v94
    v_lshlrev_b32 v22, 16, v95
    v_and_b32 v23, s30, v95
    v_pk_mul_f32 v[16:17], v[16:17], v[8:9]
    v_pk_mul_f32 v[18:19], v[18:19], v[10:11]
    v_pk_mul_f32 v[20:21], v[20:21], v[12:13]
    v_pk_mul_f32 v[22:23], v[22:23], v[14:15]
    v_cvt_pk_bf16_f32 v92, v16, v17
    v_cvt_pk_bf16_f32 v93, v18, v19
    v_cvt_pk_bf16_f32 v94, v20, v21
    v_cvt_pk_bf16_f32 v95, v22, v23
    buffer_store_dwordx4 v[92:95], v5, s[20:23], s57 offen sc0 sc1
    s_barrier
    v_lshlrev_b32 v24, 16, v156
    v_and_b32 v25, s30, v156
    v_lshlrev_b32 v26, 16, v157
    v_and_b32 v27, s30, v157
    v_lshlrev_b32 v28, 16, v158
    v_and_b32 v29, s30, v158
    v_lshlrev_b32 v30, 16, v159
    v_and_b32 v31, s30, v159
    v_pk_mul_f32 v[24:25], v[24:25], v[8:9]
    v_pk_mul_f32 v[26:27], v[26:27], v[10:11]
    v_pk_mul_f32 v[28:29], v[28:29], v[12:13]
    v_pk_mul_f32 v[30:31], v[30:31], v[14:15]
    v_cvt_pk_bf16_f32 v156, v24, v25
    v_cvt_pk_bf16_f32 v157, v26, v27
    v_cvt_pk_bf16_f32 v158, v28, v29
    v_cvt_pk_bf16_f32 v159, v30, v31
    buffer_store_dwordx4 v[156:159], v5, s[20:23], s73 offen sc0 sc1
    s_barrier
    v_lshlrev_b32 v16, 16, v96
    v_and_b32 v17, s30, v96
    v_lshlrev_b32 v18, 16, v97
    v_and_b32 v19, s30, v97
    v_lshlrev_b32 v20, 16, v98
    v_and_b32 v21, s30, v98
    v_lshlrev_b32 v22, 16, v99
    v_and_b32 v23, s30, v99
    v_pk_mul_f32 v[16:17], v[16:17], v[8:9]
    v_pk_mul_f32 v[18:19], v[18:19], v[10:11]
    v_pk_mul_f32 v[20:21], v[20:21], v[12:13]
    v_pk_mul_f32 v[22:23], v[22:23], v[14:15]
    v_cvt_pk_bf16_f32 v96, v16, v17
    v_cvt_pk_bf16_f32 v97, v18, v19
    v_cvt_pk_bf16_f32 v98, v20, v21
    v_cvt_pk_bf16_f32 v99, v22, v23
    buffer_store_dwordx4 v[96:99], v5, s[20:23], s58 offen sc0 sc1
    s_barrier
    v_lshlrev_b32 v24, 16, v160
    v_and_b32 v25, s30, v160
    v_lshlrev_b32 v26, 16, v161
    v_and_b32 v27, s30, v161
    v_lshlrev_b32 v28, 16, v162
    v_and_b32 v29, s30, v162
    v_lshlrev_b32 v30, 16, v163
    v_and_b32 v31, s30, v163
    v_pk_mul_f32 v[24:25], v[24:25], v[8:9]
    v_pk_mul_f32 v[26:27], v[26:27], v[10:11]
    v_pk_mul_f32 v[28:29], v[28:29], v[12:13]
    v_pk_mul_f32 v[30:31], v[30:31], v[14:15]
    v_cvt_pk_bf16_f32 v160, v24, v25
    v_cvt_pk_bf16_f32 v161, v26, v27
    v_cvt_pk_bf16_f32 v162, v28, v29
    v_cvt_pk_bf16_f32 v163, v30, v31
    buffer_store_dwordx4 v[160:163], v5, s[20:23], s74 offen sc0 sc1
    s_barrier
    v_lshlrev_b32 v16, 16, v100
    v_and_b32 v17, s30, v100
    v_lshlrev_b32 v18, 16, v101
    v_and_b32 v19, s30, v101
    v_lshlrev_b32 v20, 16, v102
    v_and_b32 v21, s30, v102
    v_lshlrev_b32 v22, 16, v103
    v_and_b32 v23, s30, v103
    v_pk_mul_f32 v[16:17], v[16:17], v[8:9]
    v_pk_mul_f32 v[18:19], v[18:19], v[10:11]
    v_pk_mul_f32 v[20:21], v[20:21], v[12:13]
    v_pk_mul_f32 v[22:23], v[22:23], v[14:15]
    v_cvt_pk_bf16_f32 v100, v16, v17
    v_cvt_pk_bf16_f32 v101, v18, v19
    v_cvt_pk_bf16_f32 v102, v20, v21
    v_cvt_pk_bf16_f32 v103, v22, v23
    buffer_store_dwordx4 v[100:103], v5, s[20:23], s59 offen sc0 sc1
    s_barrier
    v_lshlrev_b32 v24, 16, v164
    v_and_b32 v25, s30, v164
    v_lshlrev_b32 v26, 16, v165
    v_and_b32 v27, s30, v165
    v_lshlrev_b32 v28, 16, v166
    v_and_b32 v29, s30, v166
    v_lshlrev_b32 v30, 16, v167
    v_and_b32 v31, s30, v167
    v_pk_mul_f32 v[24:25], v[24:25], v[8:9]
    v_pk_mul_f32 v[26:27], v[26:27], v[10:11]
    v_pk_mul_f32 v[28:29], v[28:29], v[12:13]
    v_pk_mul_f32 v[30:31], v[30:31], v[14:15]
    v_cvt_pk_bf16_f32 v164, v24, v25
    v_cvt_pk_bf16_f32 v165, v26, v27
    v_cvt_pk_bf16_f32 v166, v28, v29
    v_cvt_pk_bf16_f32 v167, v30, v31
    buffer_store_dwordx4 v[164:167], v5, s[20:23], s75 offen sc0 sc1
L_exit:
    s_endpgm
.section .rodata,"a"
.p2align 6
.amdhsa_kernel standalone__channel_attn_se__vision_kernel
  .amdhsa_next_free_vgpr 168
  .amdhsa_next_free_sgpr 102
  .amdhsa_accum_offset 168
  .amdhsa_group_segment_fixed_size 0
  .amdhsa_kernarg_size 48
  .amdhsa_user_sgpr_count 2
  .amdhsa_user_sgpr_kernarg_segment_ptr 1
  .amdhsa_system_sgpr_workgroup_id_x 1
  .amdhsa_float_denorm_mode_32 3
.end_amdhsa_kernel
```
